```python
import torch

def _softmax(x, axis=-1):
    return torch.softmax(x, dim=axis)
def _gelu(x):
    return torch.nn.functional.gelu(x, approximate="tanh")
def _silu(x):
    return torch.nn.functional.silu(x)
def _sigmoid(x):
    return torch.sigmoid(x)
def _layernorm(x, axis=-1, eps=1e-5):
    m = x.mean(dim=axis, keepdim=True)
    v = x.var(dim=axis, keepdim=True, unbiased=False)
    return (x - m) / torch.sqrt(v + eps)
def _scatter_add(tgt, idx, src, axis=0):
    return tgt.clone().index_add_(axis, idx, src)
def _segment_sum(src, seg, n):
    out = torch.zeros((n,) + src.shape[1:], dtype=src.dtype)
    return out.index_add_(0, seg, src)
def _pad(x, pw):
    flat = tuple(v for pair in reversed(pw) for v in pair)
    return torch.nn.functional.pad(x, flat)

kernel_name = 'gated_mix__sliding_block_cached__sliding_block_cached__decode'

def setup_inputs():

    _w = (lambda a: (lambda t: t.to(torch.bfloat16) if t.is_floating_point() else t)(torch.as_tensor(a)))
    def _A_setup():
        B, Sq, D = 1, 1, 512
        Hq, Hkv, Sk, Dh = 32, 8, 32768, 128
        assert Hq % Hkv == 0, (Hq, Hkv)
        return {
            "x": _w((lambda *s: torch.randn(*s, dtype=torch.bfloat16) * 0.05)(B, Sq, D)),
            "k_cache": _w((lambda *s: torch.randn(*s, dtype=torch.bfloat16) * 6.4)(B, Hkv, Sk, Dh)),
            "v_cache": _w((lambda *s: torch.randn(*s, dtype=torch.bfloat16) * 0.05)(B, Hkv, Sk, Dh)),
            "wq": _w((lambda *s: torch.randn(*s, dtype=torch.bfloat16) * 6.4)(D, Hq * Dh) * (D ** -0.5)),
            "wo": _w((lambda *s: torch.randn(*s, dtype=torch.bfloat16) * 0.05)(Hq * Dh, D) * ((Hq * Dh) ** -0.5)),
        }
    _A_in = _A_setup()

    def _B_setup():
        B, Sq, D = 1, 1, 512
        Hq, Hkv, Sk, Dh = 32, 8, 32768, 128
        assert Hq % Hkv == 0, (Hq, Hkv)
        return {
            "x": _w((lambda *s: torch.randn(*s, dtype=torch.bfloat16) * 0.05)(B, Sq, D)),
            "k_cache": _w((lambda *s: torch.randn(*s, dtype=torch.bfloat16) * 6.4)(B, Hkv, Sk, Dh)),
            "v_cache": _w((lambda *s: torch.randn(*s, dtype=torch.bfloat16) * 0.05)(B, Hkv, Sk, Dh)),
            "wq": _w((lambda *s: torch.randn(*s, dtype=torch.bfloat16) * 6.4)(D, Hq * Dh) * (D ** -0.5)),
            "wo": _w((lambda *s: torch.randn(*s, dtype=torch.bfloat16) * 0.05)(Hq * Dh, D) * ((Hq * Dh) ** -0.5)),
        }
    _B_in = _B_setup()

    return {
        "A_x": _A_in["x"],
        "A_k_cache": _A_in["k_cache"],
        "A_v_cache": _A_in["v_cache"],
        "A_wq": _A_in["wq"],
        "A_wo": _A_in["wo"],
        "B_x": _B_in["x"],
        "B_k_cache": _B_in["k_cache"],
        "B_v_cache": _B_in["v_cache"],
        "B_wq": _B_in["wq"],
        "B_wo": _B_in["wo"],
        "gate_w": _w((lambda *s: torch.randn(*s, dtype=torch.bfloat16) * 0.05)(512) * 16.0),
    }

def reference(A_x, A_k_cache, A_v_cache, A_wq, A_wo, B_x, B_k_cache, B_v_cache, B_wq, B_wo, gate_w):
    def _A_ref(x, k_cache, v_cache, wq, wo):
        B, Sq, D = x.shape
        Hq, Dh = 32, 128
        Hkv, Sk = k_cache.shape[1], k_cache.shape[2]
        W = min(4096, max(256, Sk // 4))
        rep = Hq // Hkv
        q = (lambda x, *d: x.permute(*d))((x @ wq).reshape(B, Sq, Hq, Dh), 0, 2, 1, 3)
        k = (lambda x, n, axis: torch.repeat_interleave(x, n, dim=axis))(k_cache[:, :, Sk - W:, :], rep, axis=1)
        v = (lambda x, n, axis: torch.repeat_interleave(x, n, dim=axis))(v_cache[:, :, Sk - W:, :], rep, axis=1)
        scores = torch.einsum("bhqd,bhkd->bhqk", q, k) * (Dh ** -0.5)
        p = _softmax(scores, axis=-1)
        o = torch.einsum("bhqk,bhkd->bhqd", p, v)
        return (lambda x, *d: x.permute(*d))(o, 0, 2, 1, 3).reshape(B, Sq, Hq * Dh) @ wo

    def _B_ref(x, k_cache, v_cache, wq, wo):
        B, Sq, D = x.shape
        Hq, Dh = 32, 128
        Hkv, Sk = k_cache.shape[1], k_cache.shape[2]
        W = min(4096, max(256, Sk // 4))
        rep = Hq // Hkv
        q = (lambda x, *d: x.permute(*d))((x @ wq).reshape(B, Sq, Hq, Dh), 0, 2, 1, 3)
        k = (lambda x, n, axis: torch.repeat_interleave(x, n, dim=axis))(k_cache[:, :, Sk - W:, :], rep, axis=1)
        v = (lambda x, n, axis: torch.repeat_interleave(x, n, dim=axis))(v_cache[:, :, Sk - W:, :], rep, axis=1)
        scores = torch.einsum("bhqd,bhkd->bhqk", q, k) * (Dh ** -0.5)
        p = _softmax(scores, axis=-1)
        o = torch.einsum("bhqk,bhkd->bhqd", p, v)
        return (lambda x, *d: x.permute(*d))(o, 0, 2, 1, 3).reshape(B, Sq, Hq * Dh) @ wo

    x = A_x
    g = _sigmoid((x * gate_w).sum(-1, keepdims=True))
    a = _A_ref(x, A_k_cache, A_v_cache, A_wq, A_wo)
    b = _B_ref(x, B_k_cache, B_v_cache, B_wq, B_wo)
    return g * a + (1 - g) * b
```

```asm
; @launch grid=(256,1,1) block=(512,1,1) lds=24576
.amdgcn_target "amdgcn-amd-amdhsa--gfx950"
.text
.globl gated_mix__sliding_block_cached__sliding_block_cached__decode_kernel
.p2align 8
.type gated_mix__sliding_block_cached__sliding_block_cached__decode_kernel,@function
gated_mix__sliding_block_cached__sliding_block_cached__decode_kernel:
    s_cmp_ge_u32 s2, 256
    s_cbranch_scc1 END
    s_load_dwordx16 s[4:19], s[0:1], 0
    s_load_dwordx8 s[20:27], s[0:1], 64
    s_load_dwordx4 s[28:31], s[0:1], 96
    s_and_b32 s32, s2, 7
    s_lshr_b32 s33, s2, 3
    s_lshr_b32 s34, s33, 4
    s_lshl_b32 s35, s32, 1
    s_add_u32 s35, s35, s34
    s_sub_u32 s34, s32, 1
    s_cmp_eq_u32 s32, 4
    s_cselect_b32 s34, 31, s34
    s_cmp_eq_u32 s32, 7
    s_cselect_b32 s34, 3, s34
    s_min_u32 s34, s34, 31
    s_lshl_b32 s34, s34, 3
    s_add_u32 s34, s34, s33
    s_cmp_lt_u32 s33, 8
    s_cselect_b32 s34, s34, 255
    s_and_b32 s36, s33, 15
    s_lshr_b32 s37, s35, 3
    s_and_b32 s38, s35, 7
    v_lshrrev_b32 v10, 6, v0
    v_and_b32 v1, 63, v0
    v_readfirstlane_b32 s39, v10
    v_lshrrev_b32 v2, 4, v1
    v_and_b32 v3, 15, v1
    v_lshlrev_b32 v11, 4, v3
    v_lshlrev_b32 v4, 15, v2
    v_add_u32 v4, v4, v11
    v_lshlrev_b32 v7, 12, v2
    v_add_u32 v7, v7, v11
    v_lshrrev_b32 v5, 2, v3
    v_lshlrev_b32 v5, 8, v5
    v_lshlrev_b32 v10, 6, v2
    v_add_u32 v5, v5, v10
    v_and_b32 v10, 3, v1
    v_lshlrev_b32 v10, 4, v10
    v_add_u32 v5, v5, v10
    v_lshlrev_b32 v6, 4, v1
    v_lshlrev_b32 v10, 3, v2
    s_and_b32 s96, s36, 3
    s_lshr_b32 s97, s36, 2
    s_lshl_b32 s98, s38, 2
    s_add_u32 s98, s98, s97
    s_lshl_b32 s68, s96, 20
    s_lshl_b32 s99, s39, 17
    s_add_u32 s68, s68, s99
    s_lshl_b32 s99, s98, 8
    s_add_u32 s68, s68, s99
    s_add_u32 s69, s68, 8192
    s_add_u32 s70, s68, 16384
    s_add_u32 s71, s68, 24576
    s_lshl_b32 s75, s96, 8
    s_lshl_b32 s99, s39, 5
    s_add_u32 s75, s75, s99
    s_lshl_b32 s72, s38, 23
    s_add_u32 s72, s72, 7340032
    s_lshl_b32 s99, s36, 16
    s_add_u32 s72, s72, s99
    s_lshl_b32 s99, s39, 13
    s_add_u32 s72, s72, s99
    s_add_u32 s73, s72, 4096
    s_lshl_b32 s74, s98, 17
    s_lshl_b32 s99, s39, 14
    s_add_u32 s74, s74, s99
    s_lshl_b32 s99, s96, 8
    s_add_u32 s74, s74, s99
    s_cmp_eq_u32 s37, 0
    s_mov_b32 s50, 0x400000
    s_mov_b32 s51, 0x00020000
    s_mov_b32 s62, 1024
    s_mov_b32 s63, 0x00020000
    s_mov_b32 s42, 0x4000000
    s_mov_b32 s43, 0x00020000
    s_waitcnt lgkmcnt(0)
    s_cselect_b32 s48, s10, s20
    s_cselect_b32 s49, s11, s21
    s_mov_b32 s60, s4
    s_mov_b32 s61, s5
    buffer_load_dwordx2 v[8:9], v10, s[60:63], s75 offen
    buffer_load_dwordx4 v[48:51], v4, s[48:51], s68 offen nt
    buffer_load_dwordx4 v[52:55], v4, s[48:51], s69 offen nt
    buffer_load_dwordx4 v[56:59], v4, s[48:51], s70 offen nt
    buffer_load_dwordx4 v[60:63], v4, s[48:51], s71 offen nt
    s_cselect_b32 s40, s6, s16
    s_cselect_b32 s41, s7, s17
    s_mov_b32 s84, s24
    s_mov_b32 s85, s25
    s_mov_b32 s86, 1024
    s_mov_b32 s87, 0x00020000
    s_cselect_b32 s92, 1, 0
    s_cmp_eq_u32 s39, 1
    s_cselect_b32 s94, 1, 0
    s_cmp_lt_u32 s34, 32
    s_cselect_b32 s94, s94, 0
    s_cmp_eq_u32 s94, 0
    s_cbranch_scc1 SKIPG
    buffer_load_dwordx4 v[96:99], v6, s[60:63], 0 offen
    buffer_load_dwordx4 v[100:103], v6, s[84:87], 0 offen
SKIPG:
    s_cmp_eq_u32 s92, 1
    s_barrier
    buffer_load_dwordx4 v[64:67], v5, s[40:43], s72 offen offset:0 nt
    buffer_load_dwordx4 v[68:71], v5, s[40:43], s72 offen offset:1024 nt
    buffer_load_dwordx4 v[72:75], v5, s[40:43], s72 offen offset:2048 nt
    buffer_load_dwordx4 v[76:79], v5, s[40:43], s72 offen offset:3072 nt
    buffer_load_dwordx4 v[80:83], v5, s[40:43], s73 offen offset:0 nt
    buffer_load_dwordx4 v[84:87], v5, s[40:43], s73 offen offset:1024 nt
    buffer_load_dwordx4 v[88:91], v5, s[40:43], s73 offen offset:2048 nt
    buffer_load_dwordx4 v[92:95], v5, s[40:43], s73 offen offset:3072 nt
    s_load_dword s64, s[30:31], 0
    s_cselect_b32 s44, s8, s18
    s_cselect_b32 s45, s9, s19
    s_mov_b32 s46, 0x4000000
    s_mov_b32 s47, 0x00020000
    s_cselect_b32 s52, s12, s22
    s_cselect_b32 s53, s13, s23
    s_mov_b32 s54, 0x400000
    s_mov_b32 s55, 0x00020000
    s_mov_b32 s56, s30
    s_mov_b32 s57, s31
    s_mov_b32 s58, 0x400000
    s_mov_b32 s59, 0x00020000
    s_mov_b32 s76, 0x05040100
    s_mov_b32 s77, 0x07060302
    v_lshlrev_b32 v11, 5, v3
    v_lshlrev_b32 v12, 4, v2
    v_add_u32 v11, v11, v12
    s_lshl_b32 s99, s39, 9
    v_add_u32 v11, s99, v11
    s_waitcnt vmcnt(12)
    s_mov_b32 s96, 0x00010001
    s_mov_b32 s97, 0x00010001
    v_cndmask_b32 v32, 0, v8, s[96:97]
    v_cndmask_b32 v33, 0, v9, s[96:97]
    s_lshl_b64 s[96:97], s[96:97], 1
    v_cndmask_b32 v34, 0, v8, s[96:97]
    v_cndmask_b32 v35, 0, v9, s[96:97]
    s_lshl_b64 s[96:97], s[96:97], 1
    v_cndmask_b32 v36, 0, v8, s[96:97]
    v_cndmask_b32 v37, 0, v9, s[96:97]
    s_lshl_b64 s[96:97], s[96:97], 1
    v_cndmask_b32 v38, 0, v8, s[96:97]
    v_cndmask_b32 v39, 0, v9, s[96:97]
    s_lshl_b64 s[96:97], s[96:97], 1
    v_cndmask_b32 v40, 0, v8, s[96:97]
    v_cndmask_b32 v41, 0, v9, s[96:97]
    s_lshl_b64 s[96:97], s[96:97], 1
    v_cndmask_b32 v42, 0, v8, s[96:97]
    v_cndmask_b32 v43, 0, v9, s[96:97]
    s_lshl_b64 s[96:97], s[96:97], 1
    v_cndmask_b32 v44, 0, v8, s[96:97]
    v_cndmask_b32 v45, 0, v9, s[96:97]
    s_lshl_b64 s[96:97], s[96:97], 1
    v_cndmask_b32 v46, 0, v8, s[96:97]
    v_cndmask_b32 v47, 0, v9, s[96:97]
    s_waitcnt vmcnt(8)
    v_perm_b32 v16, v52, v48, s76
    v_perm_b32 v17, v60, v56, s76
    v_perm_b32 v18, v52, v48, s77
    v_perm_b32 v19, v60, v56, s77
    v_perm_b32 v20, v53, v49, s76
    v_perm_b32 v21, v61, v57, s76
    v_perm_b32 v22, v53, v49, s77
    v_perm_b32 v23, v61, v57, s77
    v_perm_b32 v24, v54, v50, s76
    v_perm_b32 v25, v62, v58, s76
    v_perm_b32 v26, v54, v50, s77
    v_perm_b32 v27, v62, v58, s77
    v_perm_b32 v28, v55, v51, s76
    v_perm_b32 v29, v63, v59, s76
    v_perm_b32 v30, v55, v51, s77
    v_perm_b32 v31, v63, v59, s77
    v_mfma_f32_16x16x16_bf16 v[12:15], v[32:33], v[16:17], 0
    v_mfma_f32_16x16x16_bf16 v[12:15], v[34:35], v[18:19], v[12:15]
    v_mfma_f32_16x16x16_bf16 v[12:15], v[36:37], v[20:21], v[12:15]
    v_mfma_f32_16x16x16_bf16 v[12:15], v[38:39], v[22:23], v[12:15]
    v_mfma_f32_16x16x16_bf16 v[12:15], v[40:41], v[24:25], v[12:15]
    v_mfma_f32_16x16x16_bf16 v[12:15], v[42:43], v[26:27], v[12:15]
    v_mfma_f32_16x16x16_bf16 v[12:15], v[44:45], v[28:29], v[12:15]
    v_mfma_f32_16x16x16_bf16 v[12:15], v[46:47], v[30:31], v[12:15]
    s_waitcnt lgkmcnt(0)
    s_mul_i32 s66, s64, 0x9E3779B1
    s_add_u32 s66, s66, 0x3C6EF372
    s_mov_b32 s67, s66
    s_mov_b32 exec_hi, 0
    s_nop 2
    ds_write_b128 v11, v[12:15] offset:0
    s_mov_b32 exec_hi, -1
    v_and_b32 v12, 7, v1
    v_lshlrev_b32 v13, 3, v12
    s_lshl_b32 s99, s39, 6
    v_add_u32 v13, s99, v13
    v_lshlrev_b32 v12, 4, v12
    s_lshl_b32 s99, s39, 7
    v_add_u32 v12, s99, v12
    s_lshl_b32 s98, s35, 4
    s_add_u32 s98, s98, s36
    s_lshl_b32 s78, s98, 10
    s_add_u32 s78, s78, 65536
    v_mov_b32 v21, s66
    v_mov_b32 v23, s66
    s_waitcnt lgkmcnt(0)
    s_barrier
    ds_read_b64 v[24:25], v13 offset:0
    ds_read_b64 v[26:27], v13 offset:512
    ds_read_b64 v[28:29], v13 offset:1024
    ds_read_b64 v[30:31], v13 offset:1536
    ds_read_b64 v[32:33], v13 offset:2048
    ds_read_b64 v[34:35], v13 offset:2560
    ds_read_b64 v[36:37], v13 offset:3072
    ds_read_b64 v[38:39], v13 offset:3584
    s_waitcnt lgkmcnt(4)
    v_pk_add_f32 v[24:25], v[24:25], v[26:27]
    v_pk_add_f32 v[28:29], v[28:29], v[30:31]
    s_waitcnt lgkmcnt(0)
    v_pk_add_f32 v[32:33], v[32:33], v[34:35]
    v_pk_add_f32 v[36:37], v[36:37], v[38:39]
    v_pk_add_f32 v[24:25], v[24:25], v[28:29]
    v_pk_add_f32 v[32:33], v[32:33], v[36:37]
    v_add_f32 v20, v24, v32
    v_add_f32 v22, v25, v33
    s_mov_b64 exec, 0xff
    buffer_store_dwordx4 v[20:23], v12, s[56:59], s78 offen sc1
    s_cmp_lg_u32 s39, 0
    s_cbranch_scc1 NOQFLAG
    s_lshl_b32 s99, s35, 11
    s_add_u32 s99, s99, 32768
    s_mov_b64 exec, 0xffff
    v_lshlrev_b32 v12, 7, v1
    s_lshl_b32 s98, s36, 2
    s_add_u32 s99, s99, s98
    buffer_store_dword v21, v12, s[56:59], s99 offen sc1
NOQFLAG:
    s_mov_b64 exec, -1
    s_cmp_eq_u32 s94, 0
    s_cbranch_scc1 SKIPG2
    v_lshlrev_b32 v104, 16, v96
    v_and_b32 v105, 0xffff0000, v96
    v_lshlrev_b32 v112, 16, v100
    v_and_b32 v113, 0xffff0000, v100
    v_lshlrev_b32 v106, 16, v97
    v_and_b32 v107, 0xffff0000, v97
    v_lshlrev_b32 v114, 16, v101
    v_and_b32 v115, 0xffff0000, v101
    v_lshlrev_b32 v108, 16, v98
    v_and_b32 v109, 0xffff0000, v98
    v_lshlrev_b32 v116, 16, v102
    v_and_b32 v117, 0xffff0000, v102
    v_lshlrev_b32 v110, 16, v99
    v_and_b32 v111, 0xffff0000, v99
    v_lshlrev_b32 v118, 16, v103
    v_and_b32 v119, 0xffff0000, v103
    v_mul_f32 v104, v104, v112
    v_mul_f32 v105, v105, v113
    v_mul_f32 v106, v106, v114
    v_mul_f32 v107, v107, v115
    v_mul_f32 v108, v108, v116
    v_mul_f32 v109, v109, v117
    v_mul_f32 v110, v110, v118
    v_mul_f32 v111, v111, v119
    v_cvt_pk_bf16_f32 v112, v104, v105
    v_cvt_pk_bf16_f32 v113, v106, v107
    v_cvt_pk_bf16_f32 v114, v108, v109
    v_cvt_pk_bf16_f32 v115, v110, v111
    v_lshlrev_b32 v104, 16, v112
    v_and_b32 v105, 0xffff0000, v112
    v_lshlrev_b32 v106, 16, v113
    v_and_b32 v107, 0xffff0000, v113
    v_lshlrev_b32 v108, 16, v114
    v_and_b32 v109, 0xffff0000, v114
    v_lshlrev_b32 v110, 16, v115
    v_and_b32 v111, 0xffff0000, v115
    v_add_f32 v104, v104, v105
    v_add_f32 v106, v106, v107
    v_add_f32 v108, v108, v109
    v_add_f32 v110, v110, v111
    v_add_f32 v104, v104, v106
    v_add_f32 v108, v108, v110
    v_add_f32 v104, v104, v108
    s_nop 1
    v_add_f32_dpp v104, v104, v104 row_ror:8 row_mask:0xf bank_mask:0xf
    s_nop 1
    v_add_f32_dpp v104, v104, v104 row_ror:4 row_mask:0xf bank_mask:0xf
    s_nop 1
    v_add_f32_dpp v104, v104, v104 row_ror:2 row_mask:0xf bank_mask:0xf
    s_nop 1
    v_add_f32_dpp v104, v104, v104 row_ror:1 row_mask:0xf bank_mask:0xf
    v_mov_b32 v105, v104
    s_nop 1
    v_permlane16_swap_b32 v104, v105
    v_add_f32 v104, v104, v105
    v_mov_b32 v105, v104
    s_nop 1
    v_permlane32_swap_b32 v104, v105
    v_add_f32 v104, v104, v105
    v_cvt_pk_bf16_f32 v104, v104, v104
    v_lshlrev_b32 v104, 16, v104
    v_mul_f32 v104, 0xBFB8AA3B, v104
    v_exp_f32 v104, v104
    s_nop 0
    v_add_f32 v104, 1.0, v104
    v_rcp_f32 v104, v104
    s_nop 0
    v_cvt_pk_bf16_f32 v104, v104, v104
    v_lshlrev_b32 v104, 16, v104
    v_sub_f32 v105, 1.0, v104
    v_cvt_pk_bf16_f32 v105, v105, v105
    v_lshlrev_b32 v105, 16, v105
    v_readfirstlane_b32 s90, v104
    v_readfirstlane_b32 s91, v105
SKIPG2:
    s_lshl_b32 s79, s35, 4
    s_add_u32 s79, s79, s36
    s_lshl_b32 s79, s79, 7
    s_add_u32 s79, s79, 32768
    v_lshrrev_b32 v12, 5, v1
    v_and_b32 v13, 31, v1
    v_lshlrev_b32 v14, 10, v12
    v_lshlrev_b32 v15, 4, v13
    v_add_u32 v14, v14, v15
    s_lshr_b32 s98, s39, 1
    s_and_b32 s97, s39, 1
    s_lshl_b32 s78, s35, 14
    s_lshl_b32 s99, s98, 12
    s_add_u32 s78, s78, s99
    s_lshl_b32 s99, s97, 9
    s_add_u32 s78, s78, s99
    s_add_u32 s78, s78, 65536
    v_lshlrev_b32 v15, 2, v13
    v_lshlrev_b32 v12, 1, v12
    v_add_u32 v15, v15, v12
    s_lshl_b32 s99, s98, 8
    s_lshl_b32 s97, s97, 7
    s_add_u32 s99, s99, s97
    v_add_u32 v15, s99, v15
    s_cmp_lg_u32 s39, 0
    s_cbranch_scc1 QH_B
    s_mov_b32 s99, 100000
QH:
    s_load_dwordx16 s[80:95], s[30:31], s79 glc
    s_sub_u32 s99, s99, 1
    s_cbranch_scc1 QH_X
    s_waitcnt lgkmcnt(0)
    s_xor_b64 s[80:81], s[80:81], s[66:67]
    s_xor_b64 s[82:83], s[82:83], s[66:67]
    s_xor_b64 s[84:85], s[84:85], s[66:67]
    s_xor_b64 s[86:87], s[86:87], s[66:67]
    s_xor_b64 s[88:89], s[88:89], s[66:67]
    s_xor_b64 s[90:91], s[90:91], s[66:67]
    s_xor_b64 s[92:93], s[92:93], s[66:67]
    s_xor_b64 s[94:95], s[94:95], s[66:67]
    s_or_b64 s[80:81], s[80:81], s[82:83]
    s_or_b64 s[80:81], s[80:81], s[84:85]
    s_or_b64 s[80:81], s[80:81], s[86:87]
    s_or_b64 s[80:81], s[80:81], s[88:89]
    s_or_b64 s[80:81], s[80:81], s[90:91]
    s_or_b64 s[80:81], s[80:81], s[92:93]
    s_or_b64 s[80:81], s[80:81], s[94:95]
    s_cbranch_scc1 QH
QH_X:
    s_waitcnt lgkmcnt(0)
QH_B:
    s_barrier
    buffer_load_dwordx4 v[16:19], v14, s[56:59], s78 offen sc1
    buffer_load_dwordx4 v[20:23], v14, s[56:59], s78 offen offset:2048 sc1
    s_barrier
    buffer_load_dwordx4 v[96:99], v6, s[44:47], s72 offen offset:0 nt
    buffer_load_dwordx4 v[100:103], v6, s[44:47], s72 offen offset:1024 nt
    buffer_load_dwordx4 v[104:107], v6, s[44:47], s72 offen offset:2048 nt
    buffer_load_dwordx4 v[108:111], v6, s[44:47], s72 offen offset:3072 nt
    buffer_load_dwordx4 v[112:115], v6, s[44:47], s73 offen offset:0 nt
    buffer_load_dwordx4 v[116:119], v6, s[44:47], s73 offen offset:1024 nt
    buffer_load_dwordx4 v[120:123], v6, s[44:47], s73 offen offset:2048 nt
    buffer_load_dwordx4 v[124:127], v6, s[44:47], s73 offen offset:3072 nt
    v_lshrrev_b32 v12, 2, v3
    v_lshlrev_b32 v12, 8, v12
    v_lshlrev_b32 v13, 6, v2
    v_add_u32 v12, v12, v13
    v_and_b32 v13, 3, v1
    v_lshlrev_b32 v13, 4, v13
    v_add_u32 v12, v12, v13
    s_mov_b32 s99, 100000
    s_waitcnt vmcnt(8)
QCHK:
    v_cmpx_eq_u32 vcc, s66, v17
    v_cmpx_eq_u32 vcc, s66, v19
    v_cmpx_eq_u32 vcc, s66, v21
    v_cmpx_eq_u32 vcc, s66, v23
    s_cmp_eq_u64 exec, -1
    s_mov_b64 exec, -1
    s_cbranch_scc1 QOK
    s_sub_u32 s99, s99, 1
    s_cbranch_scc1 QOK
    buffer_load_dwordx4 v[16:19], v14, s[56:59], s78 offen sc1
    buffer_load_dwordx4 v[20:23], v14, s[56:59], s78 offen offset:2048 sc1
    s_waitcnt vmcnt(0)
    s_branch QCHK
QOK:
    v_add_f32 v16, v16, v20
    v_add_f32 v18, v18, v22
    s_nop 1
    v_permlane32_swap_b32 v16, v18
    v_add_f32 v16, v16, v18
    v_cvt_pk_bf16_f32 v16, v16, v16
    ds_write_b16 v15, v16 offset:4096
    s_waitcnt lgkmcnt(0)
    s_barrier
    ds_read_b128 v[8:11], v12 offset:4096
    v_lshrrev_b32 v13, 2, v3
    v_lshlrev_b32 v13, 5, v13
    s_lshl_b32 s99, s39, 2
    v_add_u32 v14, s99, v13
    s_waitcnt lgkmcnt(0)
    v_mfma_f32_16x16x32_bf16 v[16:19], v[64:67], v[8:11], 0
    v_mfma_f32_16x16x32_bf16 v[20:23], v[68:71], v[8:11], 0
    v_mfma_f32_16x16x32_bf16 v[24:27], v[72:75], v[8:11], 0
    v_mfma_f32_16x16x32_bf16 v[28:31], v[76:79], v[8:11], 0
    v_mfma_f32_16x16x32_bf16 v[64:67], v[80:83], v[8:11], 0
    v_mfma_f32_16x16x32_bf16 v[68:71], v[84:87], v[8:11], 0
    v_mfma_f32_16x16x32_bf16 v[72:75], v[88:91], v[8:11], 0
    v_mfma_f32_16x16x32_bf16 v[76:79], v[92:95], v[8:11], 0
    s_nop 0
    v_mov_b32_dpp v32, v16 quad_perm:[0,0,0,0] row_mask:0xf bank_mask:0xf
    v_mov_b32_dpp v33, v20 quad_perm:[0,0,0,0] row_mask:0xf bank_mask:0xf
    v_mov_b32_dpp v34, v24 quad_perm:[0,0,0,0] row_mask:0xf bank_mask:0xf
    v_mov_b32_dpp v35, v28 quad_perm:[0,0,0,0] row_mask:0xf bank_mask:0xf
    v_add_f32_dpp v32, v17, v32 quad_perm:[1,1,1,1] row_mask:0xf bank_mask:0xf
    v_add_f32_dpp v33, v21, v33 quad_perm:[1,1,1,1] row_mask:0xf bank_mask:0xf
    v_add_f32_dpp v34, v25, v34 quad_perm:[1,1,1,1] row_mask:0xf bank_mask:0xf
    v_add_f32_dpp v35, v29, v35 quad_perm:[1,1,1,1] row_mask:0xf bank_mask:0xf
    v_add_f32_dpp v32, v18, v32 quad_perm:[2,2,2,2] row_mask:0xf bank_mask:0xf
    v_add_f32_dpp v33, v22, v33 quad_perm:[2,2,2,2] row_mask:0xf bank_mask:0xf
    v_add_f32_dpp v34, v26, v34 quad_perm:[2,2,2,2] row_mask:0xf bank_mask:0xf
    v_add_f32_dpp v35, v30, v35 quad_perm:[2,2,2,2] row_mask:0xf bank_mask:0xf
    v_add_f32_dpp v32, v19, v32 quad_perm:[3,3,3,3] row_mask:0xf bank_mask:0xf
    v_add_f32_dpp v33, v23, v33 quad_perm:[3,3,3,3] row_mask:0xf bank_mask:0xf
    v_add_f32_dpp v34, v27, v34 quad_perm:[3,3,3,3] row_mask:0xf bank_mask:0xf
    v_add_f32_dpp v35, v31, v35 quad_perm:[3,3,3,3] row_mask:0xf bank_mask:0xf
    v_mov_b32_dpp v36, v64 quad_perm:[0,0,0,0] row_mask:0xf bank_mask:0xf
    v_mov_b32_dpp v37, v68 quad_perm:[0,0,0,0] row_mask:0xf bank_mask:0xf
    v_mov_b32_dpp v38, v72 quad_perm:[0,0,0,0] row_mask:0xf bank_mask:0xf
    v_mov_b32_dpp v39, v76 quad_perm:[0,0,0,0] row_mask:0xf bank_mask:0xf
    v_add_f32_dpp v36, v65, v36 quad_perm:[1,1,1,1] row_mask:0xf bank_mask:0xf
    v_add_f32_dpp v37, v69, v37 quad_perm:[1,1,1,1] row_mask:0xf bank_mask:0xf
    v_add_f32_dpp v38, v73, v38 quad_perm:[1,1,1,1] row_mask:0xf bank_mask:0xf
    v_add_f32_dpp v39, v77, v39 quad_perm:[1,1,1,1] row_mask:0xf bank_mask:0xf
    v_add_f32_dpp v36, v66, v36 quad_perm:[2,2,2,2] row_mask:0xf bank_mask:0xf
    v_add_f32_dpp v37, v70, v37 quad_perm:[2,2,2,2] row_mask:0xf bank_mask:0xf
    v_add_f32_dpp v38, v74, v38 quad_perm:[2,2,2,2] row_mask:0xf bank_mask:0xf
    v_add_f32_dpp v39, v78, v39 quad_perm:[2,2,2,2] row_mask:0xf bank_mask:0xf
    v_add_f32_dpp v36, v67, v36 quad_perm:[3,3,3,3] row_mask:0xf bank_mask:0xf
    v_add_f32_dpp v37, v71, v37 quad_perm:[3,3,3,3] row_mask:0xf bank_mask:0xf
    v_add_f32_dpp v38, v75, v38 quad_perm:[3,3,3,3] row_mask:0xf bank_mask:0xf
    v_add_f32_dpp v39, v79, v39 quad_perm:[3,3,3,3] row_mask:0xf bank_mask:0xf
    s_mov_b32 s98, 0x3DB504F3
    v_cvt_pk_bf16_f32 v40, v32, v33
    v_cvt_pk_bf16_f32 v41, v34, v35
    v_cvt_pk_bf16_f32 v42, v36, v37
    v_cvt_pk_bf16_f32 v43, v38, v39
    v_lshlrev_b32 v32, 16, v40
    v_and_b32 v33, 0xffff0000, v40
    v_lshlrev_b32 v34, 16, v41
    v_and_b32 v35, 0xffff0000, v41
    v_lshlrev_b32 v36, 16, v42
    v_and_b32 v37, 0xffff0000, v42
    v_lshlrev_b32 v38, 16, v43
    v_and_b32 v39, 0xffff0000, v43
    v_mul_f32 v32, s98, v32
    v_mul_f32 v33, s98, v33
    v_mul_f32 v34, s98, v34
    v_mul_f32 v35, s98, v35
    v_mul_f32 v36, s98, v36
    v_mul_f32 v37, s98, v37
    v_mul_f32 v38, s98, v38
    v_mul_f32 v39, s98, v39
    v_cvt_pk_bf16_f32 v40, v32, v33
    v_cvt_pk_bf16_f32 v41, v34, v35
    v_cvt_pk_bf16_f32 v42, v36, v37
    v_cvt_pk_bf16_f32 v43, v38, v39
    v_lshlrev_b32 v32, 16, v40
    v_and_b32 v33, 0xffff0000, v40
    v_lshlrev_b32 v34, 16, v41
    v_and_b32 v35, 0xffff0000, v41
    v_lshlrev_b32 v36, 16, v42
    v_and_b32 v37, 0xffff0000, v42
    v_lshlrev_b32 v38, 16, v43
    v_and_b32 v39, 0xffff0000, v43
    v_max3_f32 v40, v32, v33, v34
    v_max3_f32 v41, v35, v36, v37
    v_max3_f32 v40, v40, v38, v39
    v_max_f32 v40, v40, v41
    v_mov_b32 v41, v40
    s_nop 1
    v_permlane32_swap_b32 v40, v41
    v_max_f32 v40, v40, v41
    v_mov_b32 v41, v40
    s_nop 1
    v_permlane16_swap_b32 v40, v41
    v_max_f32 v40, v40, v41
    s_mov_b64 exec, 0x1111
    ds_write_b32 v14, v40 offset:5120
    s_mov_b64 exec, -1
    s_waitcnt lgkmcnt(0)
    s_barrier
    ds_read_b128 v[40:43], v13 offset:5120
    ds_read_b128 v[44:47], v13 offset:5136
    s_mov_b32 s98, 0x3FB8AA3B
    s_waitcnt lgkmcnt(0)
    v_max3_f32 v40, v40, v41, v42
    v_max3_f32 v44, v44, v45, v46
    v_max3_f32 v40, v40, v43, v47
    v_max_f32 v10, v40, v44
    v_sub_f32 v32, v32, v10
    v_sub_f32 v33, v33, v10
    v_sub_f32 v34, v34, v10
    v_sub_f32 v35, v35, v10
    v_sub_f32 v36, v36, v10
    v_sub_f32 v37, v37, v10
    v_sub_f32 v38, v38, v10
    v_sub_f32 v39, v39, v10
    v_mul_f32 v32, s98, v32
    v_mul_f32 v33, s98, v33
    v_mul_f32 v34, s98, v34
    v_mul_f32 v35, s98, v35
    v_mul_f32 v36, s98, v36
    v_mul_f32 v37, s98, v37
    v_mul_f32 v38, s98, v38
    v_mul_f32 v39, s98, v39
    v_exp_f32 v32, v32
    v_exp_f32 v33, v33
    v_exp_f32 v34, v34
    v_exp_f32 v35, v35
    v_exp_f32 v36, v36
    v_exp_f32 v37, v37
    v_exp_f32 v38, v38
    v_exp_f32 v39, v39
    v_add_f32 v40, v32, v33
    v_add_f32 v41, v34, v35
    v_add_f32 v42, v36, v37
    v_add_f32 v43, v38, v39
    v_add_f32 v40, v40, v41
    v_add_f32 v42, v42, v43
    v_add_f32 v40, v40, v42
    v_cvt_pk_bf16_f32 v24, v32, v33
    v_cvt_pk_bf16_f32 v25, v34, v35
    v_cvt_pk_bf16_f32 v26, v36, v37
    v_cvt_pk_bf16_f32 v27, v38, v39
    v_mov_b32 v41, v40
    s_nop 1
    v_permlane32_swap_b32 v40, v41
    v_add_f32 v40, v40, v41
    v_mov_b32 v41, v40
    s_nop 1
    v_permlane16_swap_b32 v40, v41
    v_add_f32 v40, v40, v41
    s_mov_b64 exec, 0x1111
    ds_write_b32 v14, v40 offset:5248
    s_mov_b64 exec, -1
    s_mov_b32 s96, 0x11111111
    s_mov_b32 s97, 0x11111111
    v_cndmask_b32 v32, 0, v24, s[96:97]
    v_cndmask_b32 v33, 0, v25, s[96:97]
    v_cndmask_b32 v34, 0, v26, s[96:97]
    v_cndmask_b32 v35, 0, v27, s[96:97]
    s_lshl_b64 s[96:97], s[96:97], 1
    v_cndmask_b32 v36, 0, v24, s[96:97]
    v_cndmask_b32 v37, 0, v25, s[96:97]
    v_cndmask_b32 v38, 0, v26, s[96:97]
    v_cndmask_b32 v39, 0, v27, s[96:97]
    s_lshl_b64 s[96:97], s[96:97], 1
    v_cndmask_b32 v40, 0, v24, s[96:97]
    v_cndmask_b32 v41, 0, v25, s[96:97]
    v_cndmask_b32 v42, 0, v26, s[96:97]
    v_cndmask_b32 v43, 0, v27, s[96:97]
    s_lshl_b64 s[96:97], s[96:97], 1
    v_cndmask_b32 v44, 0, v24, s[96:97]
    v_cndmask_b32 v45, 0, v25, s[96:97]
    v_cndmask_b32 v46, 0, v26, s[96:97]
    v_cndmask_b32 v47, 0, v27, s[96:97]
    v_lshlrev_b32 v11, 9, v2
    v_lshlrev_b32 v12, 5, v3
    v_add_u32 v11, v11, v12
    s_lshl_b32 s99, s39, 11
    v_add_u32 v11, s99, v11
    v_and_b32 v12, 31, v1
    v_lshlrev_b32 v13, 3, v12
    s_lshl_b32 s99, s39, 8
    v_add_u32 v13, s99, v13
    v_lshlrev_b32 v12, 4, v12
    s_lshl_b32 s98, s35, 4
    s_add_u32 s98, s98, s36
    s_lshl_b32 s78, s98, 12
    s_lshl_b32 s99, s39, 9
    s_add_u32 s78, s78, s99
    s_add_u32 s78, s78, 1048576
    s_lshr_b32 s98, s39, 1
    s_lshl_b32 s99, s98, 2
    v_readlane_b32 s65, v10, s99
    s_lshl_b32 s99, s98, 5
    v_mov_b32 v14, s99
    s_waitcnt vmcnt(4)
    v_perm_b32 v64, v100, v96, s76
    v_perm_b32 v65, v108, v104, s76
    v_perm_b32 v66, v100, v96, s77
    v_perm_b32 v67, v108, v104, s77
    v_perm_b32 v68, v101, v97, s76
    v_perm_b32 v69, v109, v105, s76
    v_perm_b32 v70, v101, v97, s77
    v_perm_b32 v71, v109, v105, s77
    v_perm_b32 v72, v102, v98, s76
    v_perm_b32 v73, v110, v106, s76
    v_perm_b32 v74, v102, v98, s77
    v_perm_b32 v75, v110, v106, s77
    v_perm_b32 v76, v103, v99, s76
    v_perm_b32 v77, v111, v107, s76
    v_perm_b32 v78, v103, v99, s77
    v_perm_b32 v79, v111, v107, s77
    v_mfma_f32_16x16x16_bf16 v[16:19], v[32:33], v[64:65], 0
    v_mfma_f32_16x16x16_bf16 v[20:23], v[32:33], v[72:73], 0
    v_mfma_f32_16x16x16_bf16 v[16:19], v[36:37], v[66:67], v[16:19]
    v_mfma_f32_16x16x16_bf16 v[20:23], v[36:37], v[74:75], v[20:23]
    v_mfma_f32_16x16x16_bf16 v[16:19], v[40:41], v[68:69], v[16:19]
    v_mfma_f32_16x16x16_bf16 v[20:23], v[40:41], v[76:77], v[20:23]
    v_mfma_f32_16x16x16_bf16 v[16:19], v[44:45], v[70:71], v[16:19]
    v_mfma_f32_16x16x16_bf16 v[20:23], v[44:45], v[78:79], v[20:23]
    s_waitcnt vmcnt(0)
    buffer_load_dwordx4 v[48:51], v7, s[52:55], s74 offen offset:0 nt
    buffer_load_dwordx4 v[52:55], v7, s[52:55], s74 offen offset:1024 nt
    v_perm_b32 v80, v116, v112, s76
    v_perm_b32 v81, v124, v120, s76
    v_perm_b32 v82, v116, v112, s77
    v_perm_b32 v83, v124, v120, s77
    v_perm_b32 v84, v117, v113, s76
    v_perm_b32 v85, v125, v121, s76
    v_perm_b32 v86, v117, v113, s77
    v_perm_b32 v87, v125, v121, s77
    v_perm_b32 v88, v118, v114, s76
    v_perm_b32 v89, v126, v122, s76
    v_perm_b32 v90, v118, v114, s77
    v_perm_b32 v91, v126, v122, s77
    v_perm_b32 v92, v119, v115, s76
    v_perm_b32 v93, v127, v123, s76
    v_perm_b32 v94, v119, v115, s77
    v_perm_b32 v95, v127, v123, s77
    v_mfma_f32_16x16x16_bf16 v[16:19], v[34:35], v[80:81], v[16:19]
    v_mfma_f32_16x16x16_bf16 v[20:23], v[34:35], v[88:89], v[20:23]
    v_mfma_f32_16x16x16_bf16 v[16:19], v[38:39], v[82:83], v[16:19]
    v_mfma_f32_16x16x16_bf16 v[20:23], v[38:39], v[90:91], v[20:23]
    v_mfma_f32_16x16x16_bf16 v[16:19], v[42:43], v[84:85], v[16:19]
    v_mfma_f32_16x16x16_bf16 v[20:23], v[42:43], v[92:93], v[20:23]
    v_mfma_f32_16x16x16_bf16 v[16:19], v[46:47], v[86:87], v[16:19]
    v_mfma_f32_16x16x16_bf16 v[20:23], v[46:47], v[94:95], v[20:23]
    s_nop 6
    ds_write_b128 v11, v[16:19] offset:8192
    ds_write_b128 v11, v[20:23] offset:8208
    v_mov_b32 v21, s66
    v_mov_b32 v23, s66
    s_waitcnt lgkmcnt(0)
    s_barrier
    ds_read_b64 v[24:25], v13 offset:8192
    ds_read_b64 v[26:27], v13 offset:10240
    ds_read_b64 v[28:29], v13 offset:12288
    ds_read_b64 v[30:31], v13 offset:14336
    ds_read_b64 v[32:33], v13 offset:16384
    ds_read_b64 v[34:35], v13 offset:18432
    ds_read_b64 v[36:37], v13 offset:20480
    ds_read_b64 v[38:39], v13 offset:22528
    ds_read_b128 v[40:43], v14 offset:5248
    ds_read_b128 v[44:47], v14 offset:5264
    s_waitcnt lgkmcnt(6)
    v_pk_add_f32 v[24:25], v[24:25], v[26:27]
    v_pk_add_f32 v[28:29], v[28:29], v[30:31]
    s_waitcnt lgkmcnt(2)
    v_pk_add_f32 v[32:33], v[32:33], v[34:35]
    v_pk_add_f32 v[36:37], v[36:37], v[38:39]
    v_pk_add_f32 v[24:25], v[24:25], v[28:29]
    v_pk_add_f32 v[32:33], v[32:33], v[36:37]
    v_add_f32 v20, v24, v32
    v_add_f32 v22, v25, v33
    s_mov_b32 exec_hi, 0
    buffer_store_dwordx4 v[20:23], v12, s[56:59], s78 offen sc1
    s_and_b32 s99, s39, 1
    s_cmp_lg_u32 s99, 0
    s_cbranch_scc1 NOSTAT
    s_waitcnt lgkmcnt(0)
    v_pk_add_f32 v[40:41], v[40:41], v[42:43]
    v_pk_add_f32 v[44:45], v[44:45], v[46:47]
    v_pk_add_f32 v[40:41], v[40:41], v[44:45]
    v_mov_b32 v24, s65
    v_mov_b32 v25, s66
    v_add_f32 v26, v40, v41
    v_mov_b32 v27, s66
    s_lshl_b32 s98, s35, 2
    s_lshr_b32 s99, s39, 1
    s_add_u32 s98, s98, s99
    s_lshl_b32 s97, s98, 8
    s_lshl_b32 s99, s36, 4
    s_add_u32 s97, s97, s99
    s_add_u32 s97, s97, 16384
    s_lshl_b32 s98, s98, 9
    s_lshl_b32 s99, s36, 2
    s_add_u32 s98, s98, s99
    s_add_u32 s98, s98, 327680
    v_lshlrev_b32 v28, 7, v1
    s_mov_b64 exec, 1
    buffer_store_dwordx4 v[24:27], v28, s[56:59], s97 offen sc1
    s_mov_b64 exec, 15
    buffer_store_dword v25, v28, s[56:59], s98 offen sc1
NOSTAT:
    s_mov_b64 exec, -1
    s_waitcnt lgkmcnt(0)
    buffer_load_dwordx4 v[56:59], v7, s[52:55], s74 offen offset:2048 nt
    buffer_load_dwordx4 v[60:63], v7, s[52:55], s74 offen offset:3072 nt
    s_lshr_b32 s98, s36, 2
    s_lshl_b32 s99, s35, 2
    s_add_u32 s98, s98, s99
    s_lshl_b32 s79, s35, 4
    s_add_u32 s79, s79, s36
    s_lshl_b32 s79, s79, 7
    s_add_u32 s79, s79, 327680
    s_lshl_b32 s97, s98, 8
    s_add_u32 s97, s97, 16384
    s_lshl_b32 s78, s35, 16
    s_lshr_b32 s98, s36, 2
    s_lshl_b32 s98, s98, 10
    s_add_u32 s78, s78, s98
    s_lshl_b32 s98, s39, 7
    s_add_u32 s78, s78, s98
    s_add_u32 s78, s78, 1048576
    v_lshlrev_b32 v12, 12, v3
    v_lshlrev_b32 v13, 5, v2
    v_add_u32 v12, v12, v13
    v_lshlrev_b32 v13, 4, v3
    v_lshlrev_b32 v11, 5, v3
    v_lshlrev_b32 v14, 4, v2
    v_add_u32 v11, v11, v14
    s_lshl_b32 s99, s39, 9
    v_add_u32 v11, s99, v11
    s_cmp_lg_u32 s39, 0
    s_cbranch_scc1 OH_B
    s_mov_b32 s99, 100000
OH:
    s_load_dwordx16 s[80:95], s[30:31], s79 glc
    s_sub_u32 s99, s99, 1
    s_cbranch_scc1 OH_X
    s_waitcnt lgkmcnt(0)
    s_mov_b32 s98, 0
    s_cmp_eq_u64 s[80:81], s[66:67]
    s_addc_u32 s98, s98, 0
    s_cmp_eq_u64 s[82:83], s[66:67]
    s_addc_u32 s98, s98, 0
    s_cmp_eq_u64 s[84:85], s[66:67]
    s_addc_u32 s98, s98, 0
    s_cmp_eq_u64 s[86:87], s[66:67]
    s_addc_u32 s98, s98, 0
    s_cmp_eq_u64 s[88:89], s[66:67]
    s_addc_u32 s98, s98, 0
    s_cmp_eq_u64 s[90:91], s[66:67]
    s_addc_u32 s98, s98, 0
    s_cmp_eq_u64 s[92:93], s[66:67]
    s_addc_u32 s98, s98, 0
    s_cmp_eq_u64 s[94:95], s[66:67]
    s_addc_u32 s98, s98, 0
    s_cmp_lt_u32 s98, 6
    s_cbranch_scc1 OH
OH_X:
    s_waitcnt lgkmcnt(0)
OH_B:
    s_barrier
    buffer_load_dwordx4 v[64:67], v12, s[56:59], s78 offen sc1
    buffer_load_dwordx4 v[68:71], v12, s[56:59], s78 offen offset:16 sc1
    buffer_load_dwordx4 v[72:75], v13, s[56:59], s97 offen sc1
    s_waitcnt vmcnt(3)
    v_perm_b32 v16, v52, v48, s76
    v_perm_b32 v17, v60, v56, s76
    v_perm_b32 v18, v52, v48, s77
    v_perm_b32 v19, v60, v56, s77
    v_perm_b32 v20, v53, v49, s76
    v_perm_b32 v21, v61, v57, s76
    v_perm_b32 v22, v53, v49, s77
    v_perm_b32 v23, v61, v57, s77
    v_perm_b32 v24, v54, v50, s76
    v_perm_b32 v25, v62, v58, s76
    v_perm_b32 v26, v54, v50, s77
    v_perm_b32 v27, v62, v58, s77
    v_perm_b32 v28, v55, v51, s76
    v_perm_b32 v29, v63, v59, s76
    v_perm_b32 v30, v55, v51, s77
    v_perm_b32 v31, v63, v59, s77
    s_mov_b32 s99, 100000
    s_mov_b32 s98, 0x3FB8AA3B
    s_waitcnt vmcnt(0)
OCHK:
    v_cmpx_eq_u32 vcc, s66, v65
    v_cmpx_eq_u32 vcc, s66, v67
    v_cmpx_eq_u32 vcc, s66, v69
    v_cmpx_eq_u32 vcc, s66, v71
    v_cmpx_eq_u32 vcc, s66, v73
    v_cmpx_eq_u32 vcc, s66, v75
    s_not_b64 exec, exec
    s_cbranch_scc0 OOK
    s_sub_u32 s99, s99, 1
    s_cbranch_scc1 OOK
    buffer_load_dwordx4 v[64:67], v12, s[56:59], s78 offen sc1
    buffer_load_dwordx4 v[68:71], v12, s[56:59], s78 offen offset:16 sc1
    buffer_load_dwordx4 v[72:75], v13, s[56:59], s97 offen sc1
    s_mov_b64 exec, -1
    s_waitcnt vmcnt(0)
    s_branch OCHK
OOK:
    s_mov_b64 exec, -1
    s_nop 4
    v_max_f32_dpp v76, v72, v72 row_ror:8 row_mask:0xf bank_mask:0xf
    s_nop 1
    v_max_f32_dpp v76, v76, v76 row_ror:4 row_mask:0xf bank_mask:0xf
    s_nop 1
    v_max_f32_dpp v76, v76, v76 row_ror:2 row_mask:0xf bank_mask:0xf
    s_nop 1
    v_max_f32_dpp v76, v76, v76 row_ror:1 row_mask:0xf bank_mask:0xf
    v_sub_f32 v76, v72, v76
    v_mul_f32 v76, s98, v76
    v_exp_f32 v76, v76
    s_nop 0
    v_mul_f32 v80, v76, v74
    v_mul_f32 v81, v76, v64
    v_mul_f32 v82, v76, v66
    v_mul_f32 v83, v76, v68
    v_mul_f32 v84, v76, v70
    v_add_f32_dpp v80, v80, v80 row_ror:8 row_mask:0xf bank_mask:0xf
    v_add_f32_dpp v81, v81, v81 row_ror:8 row_mask:0xf bank_mask:0xf
    v_add_f32_dpp v82, v82, v82 row_ror:8 row_mask:0xf bank_mask:0xf
    v_add_f32_dpp v83, v83, v83 row_ror:8 row_mask:0xf bank_mask:0xf
    v_add_f32_dpp v84, v84, v84 row_ror:8 row_mask:0xf bank_mask:0xf
    v_add_f32_dpp v80, v80, v80 row_ror:4 row_mask:0xf bank_mask:0xf
    v_add_f32_dpp v81, v81, v81 row_ror:4 row_mask:0xf bank_mask:0xf
    v_add_f32_dpp v82, v82, v82 row_ror:4 row_mask:0xf bank_mask:0xf
    v_add_f32_dpp v83, v83, v83 row_ror:4 row_mask:0xf bank_mask:0xf
    v_add_f32_dpp v84, v84, v84 row_ror:4 row_mask:0xf bank_mask:0xf
    v_add_f32_dpp v80, v80, v80 row_ror:2 row_mask:0xf bank_mask:0xf
    v_add_f32_dpp v81, v81, v81 row_ror:2 row_mask:0xf bank_mask:0xf
    v_add_f32_dpp v82, v82, v82 row_ror:2 row_mask:0xf bank_mask:0xf
    v_add_f32_dpp v83, v83, v83 row_ror:2 row_mask:0xf bank_mask:0xf
    v_add_f32_dpp v84, v84, v84 row_ror:2 row_mask:0xf bank_mask:0xf
    v_add_f32_dpp v80, v80, v80 row_ror:1 row_mask:0xf bank_mask:0xf
    v_add_f32_dpp v81, v81, v81 row_ror:1 row_mask:0xf bank_mask:0xf
    v_add_f32_dpp v82, v82, v82 row_ror:1 row_mask:0xf bank_mask:0xf
    v_add_f32_dpp v83, v83, v83 row_ror:1 row_mask:0xf bank_mask:0xf
    v_add_f32_dpp v84, v84, v84 row_ror:1 row_mask:0xf bank_mask:0xf
    v_rcp_f32 v80, v80
    s_nop 0
    v_mul_f32 v81, v81, v80
    v_mul_f32 v82, v82, v80
    v_mul_f32 v83, v83, v80
    v_mul_f32 v84, v84, v80
    v_cvt_pk_bf16_f32 v8, v81, v82
    v_cvt_pk_bf16_f32 v9, v83, v84
    s_mov_b32 s96, 0x00010001
    s_mov_b32 s97, 0x00010001
    v_cndmask_b32 v32, 0, v8, s[96:97]
    v_cndmask_b32 v33, 0, v9, s[96:97]
    s_lshl_b64 s[96:97], s[96:97], 1
    v_cndmask_b32 v34, 0, v8, s[96:97]
    v_cndmask_b32 v35, 0, v9, s[96:97]
    s_lshl_b64 s[96:97], s[96:97], 1
    v_cndmask_b32 v36, 0, v8, s[96:97]
    v_cndmask_b32 v37, 0, v9, s[96:97]
    s_lshl_b64 s[96:97], s[96:97], 1
    v_cndmask_b32 v38, 0, v8, s[96:97]
    v_cndmask_b32 v39, 0, v9, s[96:97]
    s_lshl_b64 s[96:97], s[96:97], 1
    v_cndmask_b32 v40, 0, v8, s[96:97]
    v_cndmask_b32 v41, 0, v9, s[96:97]
    s_lshl_b64 s[96:97], s[96:97], 1
    v_cndmask_b32 v42, 0, v8, s[96:97]
    v_cndmask_b32 v43, 0, v9, s[96:97]
    s_lshl_b64 s[96:97], s[96:97], 1
    v_cndmask_b32 v44, 0, v8, s[96:97]
    v_cndmask_b32 v45, 0, v9, s[96:97]
    s_lshl_b64 s[96:97], s[96:97], 1
    v_cndmask_b32 v46, 0, v8, s[96:97]
    v_cndmask_b32 v47, 0, v9, s[96:97]
    v_mfma_f32_16x16x16_bf16 v[12:15], v[32:33], v[16:17], 0
    v_mfma_f32_16x16x16_bf16 v[12:15], v[34:35], v[18:19], v[12:15]
    v_mfma_f32_16x16x16_bf16 v[12:15], v[36:37], v[20:21], v[12:15]
    v_mfma_f32_16x16x16_bf16 v[12:15], v[38:39], v[22:23], v[12:15]
    v_mfma_f32_16x16x16_bf16 v[12:15], v[40:41], v[24:25], v[12:15]
    v_mfma_f32_16x16x16_bf16 v[12:15], v[42:43], v[26:27], v[12:15]
    v_mfma_f32_16x16x16_bf16 v[12:15], v[44:45], v[28:29], v[12:15]
    v_mfma_f32_16x16x16_bf16 v[12:15], v[46:47], v[30:31], v[12:15]
    s_mov_b32 exec_hi, 0
    s_nop 6
    ds_write_b128 v11, v[12:15] offset:0
    s_mov_b32 exec_hi, -1
    v_lshlrev_b32 v13, 3, v1
    v_lshlrev_b32 v12, 4, v1
    v_mov_b32 v21, s66
    v_mov_b32 v23, s66
    s_waitcnt lgkmcnt(0)
    s_barrier
    s_cmp_eq_u32 s39, 0
    s_cbranch_scc1 FPUB
    s_cmp_lg_u32 s39, 1
    s_cbranch_scc1 END
    s_cmp_lt_u32 s34, 32
    s_cbranch_scc1 FINAL
    s_branch END
FPUB:
    ds_read_b64 v[24:25], v13 offset:0
    ds_read_b64 v[26:27], v13 offset:512
    ds_read_b64 v[28:29], v13 offset:1024
    ds_read_b64 v[30:31], v13 offset:1536
    ds_read_b64 v[32:33], v13 offset:2048
    ds_read_b64 v[34:35], v13 offset:2560
    ds_read_b64 v[36:37], v13 offset:3072
    ds_read_b64 v[38:39], v13 offset:3584
    s_and_b32 s98, s36, 3
    s_lshl_b32 s98, s98, 6
    s_lshl_b32 s99, s35, 2
    s_add_u32 s98, s98, s99
    s_lshr_b32 s99, s36, 2
    s_add_u32 s98, s98, s99
    s_lshl_b32 s98, s98, 10
    s_add_u32 s98, s98, 524288
    s_waitcnt lgkmcnt(4)
    v_pk_add_f32 v[24:25], v[24:25], v[26:27]
    v_pk_add_f32 v[28:29], v[28:29], v[30:31]
    s_waitcnt lgkmcnt(0)
    v_pk_add_f32 v[32:33], v[32:33], v[34:35]
    v_pk_add_f32 v[36:37], v[36:37], v[38:39]
    v_pk_add_f32 v[24:25], v[24:25], v[28:29]
    v_pk_add_f32 v[32:33], v[32:33], v[36:37]
    v_add_f32 v20, v24, v32
    v_add_f32 v22, v25, v33
    buffer_store_dwordx4 v[20:23], v12, s[56:59], s98 offen sc1
    s_branch END
FINAL:
    s_mov_b32 s46, 1024
    s_mov_b32 s47, 0x00020000
    v_lshrrev_b32 v13, 3, v1
    v_lshlrev_b32 v13, 10, v13
    v_and_b32 v14, 7, v1
    v_lshlrev_b32 v14, 4, v14
    v_add_u32 v13, v13, v14
    s_lshr_b32 s98, s34, 3
    s_lshl_b32 s98, s98, 16
    s_and_b32 s99, s34, 7
    s_lshl_b32 s99, s99, 7
    s_add_u32 s98, s98, s99
    s_add_u32 s80, s98, 524288
    s_add_u32 s81, s80, 8192
    s_add_u32 s82, s80, 16384
    s_add_u32 s83, s80, 24576
    s_add_u32 s84, s80, 32768
    s_add_u32 s85, s80, 40960
    s_add_u32 s86, s80, 49152
    s_add_u32 s87, s80, 57344
    buffer_load_dwordx4 v[96:99], v13, s[56:59], s80 offen sc1
    buffer_load_dwordx4 v[100:103], v13, s[56:59], s81 offen sc1
    buffer_load_dwordx4 v[104:107], v13, s[56:59], s82 offen sc1
    buffer_load_dwordx4 v[108:111], v13, s[56:59], s83 offen sc1
    buffer_load_dwordx4 v[112:115], v13, s[56:59], s84 offen sc1
    buffer_load_dwordx4 v[116:119], v13, s[56:59], s85 offen sc1
    buffer_load_dwordx4 v[120:123], v13, s[56:59], s86 offen sc1
    buffer_load_dwordx4 v[124:127], v13, s[56:59], s87 offen sc1
    v_mov_b32 v10, s90
    v_mov_b32 v11, s91
    s_mov_b32 s96, 0
    s_mov_b32 s97, -1
    v_cndmask_b32 v8, v10, v11, s[96:97]
    v_and_b32 v14, 7, v1
    v_lshlrev_b32 v14, 2, v14
    v_lshrrev_b32 v15, 4, v1
    v_and_b32 v15, 1, v15
    v_lshlrev_b32 v15, 1, v15
    v_add_u32 v14, v14, v15
    s_lshl_b32 s98, s34, 5
    s_mov_b32 s44, s26
    s_mov_b32 s45, s27
    s_mov_b32 s99, 100000
    buffer_load_dwordx4 v[64:67], v13, s[56:59], s80 offen sc1
    buffer_load_dwordx4 v[68:71], v13, s[56:59], s81 offen sc1
    buffer_load_dwordx4 v[72:75], v13, s[56:59], s82 offen sc1
    buffer_load_dwordx4 v[76:79], v13, s[56:59], s83 offen sc1
    buffer_load_dwordx4 v[80:83], v13, s[56:59], s84 offen sc1
    buffer_load_dwordx4 v[84:87], v13, s[56:59], s85 offen sc1
    buffer_load_dwordx4 v[88:91], v13, s[56:59], s86 offen sc1
    buffer_load_dwordx4 v[92:95], v13, s[56:59], s87 offen sc1
FCHK:
    s_waitcnt vmcnt(8)
    v_cmpx_eq_u32 vcc, s66, v97
    v_cmpx_eq_u32 vcc, s66, v99
    v_cmpx_eq_u32 vcc, s66, v101
    v_cmpx_eq_u32 vcc, s66, v103
    v_cmpx_eq_u32 vcc, s66, v105
    v_cmpx_eq_u32 vcc, s66, v107
    v_cmpx_eq_u32 vcc, s66, v109
    v_cmpx_eq_u32 vcc, s66, v111
    v_cmpx_eq_u32 vcc, s66, v113
    v_cmpx_eq_u32 vcc, s66, v115
    v_cmpx_eq_u32 vcc, s66, v117
    v_cmpx_eq_u32 vcc, s66, v119
    v_cmpx_eq_u32 vcc, s66, v121
    v_cmpx_eq_u32 vcc, s66, v123
    v_cmpx_eq_u32 vcc, s66, v125
    v_cmpx_eq_u32 vcc, s66, v127
    s_not_b64 exec, exec
    s_cbranch_scc0 FOK
    buffer_load_dwordx4 v[96:99], v13, s[56:59], s80 offen sc1
    buffer_load_dwordx4 v[100:103], v13, s[56:59], s81 offen sc1
    buffer_load_dwordx4 v[104:107], v13, s[56:59], s82 offen sc1
    buffer_load_dwordx4 v[108:111], v13, s[56:59], s83 offen sc1
    buffer_load_dwordx4 v[112:115], v13, s[56:59], s84 offen sc1
    buffer_load_dwordx4 v[116:119], v13, s[56:59], s85 offen sc1
    buffer_load_dwordx4 v[120:123], v13, s[56:59], s86 offen sc1
    buffer_load_dwordx4 v[124:127], v13, s[56:59], s87 offen sc1
    s_mov_b64 exec, -1
    s_waitcnt vmcnt(8)
    v_cmpx_eq_u32 vcc, s66, v65
    v_cmpx_eq_u32 vcc, s66, v67
    v_cmpx_eq_u32 vcc, s66, v69
    v_cmpx_eq_u32 vcc, s66, v71
    v_cmpx_eq_u32 vcc, s66, v73
    v_cmpx_eq_u32 vcc, s66, v75
    v_cmpx_eq_u32 vcc, s66, v77
    v_cmpx_eq_u32 vcc, s66, v79
    v_cmpx_eq_u32 vcc, s66, v81
    v_cmpx_eq_u32 vcc, s66, v83
    v_cmpx_eq_u32 vcc, s66, v85
    v_cmpx_eq_u32 vcc, s66, v87
    v_cmpx_eq_u32 vcc, s66, v89
    v_cmpx_eq_u32 vcc, s66, v91
    v_cmpx_eq_u32 vcc, s66, v93
    v_cmpx_eq_u32 vcc, s66, v95
    s_not_b64 exec, exec
    s_cbranch_scc0 FOKB
    buffer_load_dwordx4 v[64:67], v13, s[56:59], s80 offen sc1
    buffer_load_dwordx4 v[68:71], v13, s[56:59], s81 offen sc1
    buffer_load_dwordx4 v[72:75], v13, s[56:59], s82 offen sc1
    buffer_load_dwordx4 v[76:79], v13, s[56:59], s83 offen sc1
    buffer_load_dwordx4 v[80:83], v13, s[56:59], s84 offen sc1
    buffer_load_dwordx4 v[84:87], v13, s[56:59], s85 offen sc1
    buffer_load_dwordx4 v[88:91], v13, s[56:59], s86 offen sc1
    buffer_load_dwordx4 v[92:95], v13, s[56:59], s87 offen sc1
    s_mov_b64 exec, -1
    s_sub_u32 s99, s99, 1
    s_cbranch_scc0 FCHK
    s_branch FOK
FOKB:
    s_mov_b64 exec, -1
    v_add_f32 v32, v64, v68
    v_add_f32 v33, v66, v70
    v_add_f32 v34, v72, v76
    v_add_f32 v35, v74, v78
    v_add_f32 v36, v80, v84
    v_add_f32 v37, v82, v86
    v_add_f32 v38, v88, v92
    v_add_f32 v39, v90, v94
    s_branch FCOM
FOK:
    s_mov_b64 exec, -1
    v_add_f32 v32, v96, v100
    v_add_f32 v33, v98, v102
    v_add_f32 v34, v104, v108
    v_add_f32 v35, v106, v110
    v_add_f32 v36, v112, v116
    v_add_f32 v37, v114, v118
    v_add_f32 v38, v120, v124
    v_add_f32 v39, v122, v126
FCOM:
    v_add_f32 v48, v32, v34
    v_add_f32 v50, v36, v38
    v_add_f32 v49, v33, v35
    v_add_f32 v51, v37, v39
    v_permlane32_swap_b32 v48, v50
    s_nop 0
    v_permlane32_swap_b32 v49, v51
    v_add_f32 v48, v48, v50
    v_add_f32 v49, v49, v51
    s_nop 1
    v_permlane16_swap_b32 v48, v49
    v_add_f32 v48, v48, v49
    s_nop 1
    v_add_f32_dpp v48, v48, v48 row_ror:8 row_mask:0xf bank_mask:0xf
    v_cvt_pk_bf16_f32 v48, v48, v48
    v_lshlrev_b32 v48, 16, v48
    v_mul_f32 v48, v48, v8
    v_cvt_pk_bf16_f32 v48, v48, v48
    v_lshlrev_b32 v48, 16, v48
    v_mov_b32 v49, v48
    s_nop 1
    v_permlane32_swap_b32 v48, v49
    v_add_f32 v48, v48, v49
    v_cvt_pk_bf16_f32 v48, v48, v48
    s_mov_b32 exec_lo, 0x00ff00ff
    s_mov_b32 exec_hi, 0
    buffer_store_short v48, v14, s[44:47], s98 offen
    s_cmp_lg_u32 s34, 0
    s_cbranch_scc1 NOEPOCH
    s_add_u32 s64, s64, 1
    v_mov_b32 v2, s64
    v_mov_b32 v3, 0
    s_mov_b64 exec, 1
    buffer_store_dword v2, v3, s[56:59], 0 offen
NOEPOCH:
END:
s_endpgm
.section .rodata,"a"
.p2align 6
.amdhsa_kernel gated_mix__sliding_block_cached__sliding_block_cached__decode_kernel
  .amdhsa_next_free_vgpr 128
  .amdhsa_next_free_sgpr 102
  .amdhsa_accum_offset 128
  .amdhsa_group_segment_fixed_size 0
  .amdhsa_kernarg_size 112
  .amdhsa_user_sgpr_count 2
  .amdhsa_user_sgpr_kernarg_segment_ptr 1
  .amdhsa_system_sgpr_workgroup_id_x 1
.end_amdhsa_kernel
```
